```python
import torch

def _softmax(x, axis=-1):
    return torch.softmax(x, dim=axis)
def _gelu(x):
    return torch.nn.functional.gelu(x, approximate="tanh")
def _silu(x):
    return torch.nn.functional.silu(x)
def _sigmoid(x):
    return torch.sigmoid(x)
def _layernorm(x, axis=-1, eps=1e-5):
    m = x.mean(dim=axis, keepdim=True)
    v = x.var(dim=axis, keepdim=True, unbiased=False)
    return (x - m) / torch.sqrt(v + eps)
def _scatter_add(tgt, idx, src, axis=0):
    return tgt.clone().index_add_(axis, idx, src)
def _segment_sum(src, seg, n):
    out = torch.zeros((n,) + src.shape[1:], dtype=src.dtype)
    return out.index_add_(0, seg, src)
def _pad(x, pw):
    flat = tuple(v for pair in reversed(pw) for v in pair)
    return torch.nn.functional.pad(x, flat)

kernel_name = 'standalone__fm_second_order__recsys'

def setup_inputs():

    _w = (lambda a: (lambda t: t.to(torch.bfloat16) if t.is_floating_point() else t)(torch.as_tensor(a)))
    B, F, D, V = 4096, 26, 128, min(1000000, 100000)
    return {
        "idx": _w((lambda lo, hi, *s: torch.randint(lo, hi, s))(0, V, B, F).to(torch.int64)),
        "table": _w((lambda *s: torch.randn(*s, dtype=torch.bfloat16) * 0.05)(V, D)),
    }

def reference(idx, table):
    emb = table[idx]
    sum_sq = emb.sum(axis=1) ** 2
    sq_sum = (emb ** 2).sum(axis=1)
    return 0.5 * (sum_sq - sq_sum).sum(axis=-1)
```

```asm
; @launch grid=(512,1,1) block=(256,1,1) lds=0
.amdgcn_target "amdgcn-amd-amdhsa--gfx950"
.text
.globl standalone__fm_second_order__recsys_kernel
.p2align 8
.type standalone__fm_second_order__recsys_kernel,@function
standalone__fm_second_order__recsys_kernel:
    s_load_dwordx2 s[12:13], s[0:1], 0
    s_load_dwordx2 s[16:17], s[0:1], 8
    s_load_dwordx2 s[20:21], s[0:1], 16
    s_cmp_ge_u32 s2, 512
    s_cbranch_scc1 L_end
    s_lshr_b32 s4, s2, 7
    s_lshl_b32 s2, s2, 2
    s_and_b32 s2, s2, 511
    s_or_b32 s2, s2, s4
    v_bfe_u32 v1, v0, 3, 1
    v_lshrrev_b32 v2, 6, v0
    v_bfe_u32 v3, v0, 5, 1
    v_lshl_add_u32 v1, v1, 1, v3
    v_lshl_add_u32 v1, v2, 2, v1
    v_mul_u32_u24 v1, 52, v1
    s_mul_i32 s3, s2, 832
    s_mov_b32 s14, 425984
    s_mov_b32 s15, 0x00020000
    s_mov_b32 s18, 25600000
    s_mov_b32 s19, 0x00020000
    s_waitcnt lgkmcnt(0)
    buffer_load_dwordx4 v[24:27], v1, s[12:15], s3 offen offset:0
    buffer_load_dwordx4 v[28:31], v1, s[12:15], s3 offen offset:16
    buffer_load_dwordx4 v[32:35], v1, s[12:15], s3 offen offset:32
    buffer_load_dword v36, v1, s[12:15], s3 offen offset:48
    s_mov_b32 s22, 8192
    s_mov_b32 s23, 0x00020000
    v_lshl_add_u32 v2, v2, 1, v3
    v_lshlrev_b32 v2, 1, v2
    v_and_b32 v3, 7, v0
    v_lshlrev_b32 v3, 4, v3
    v_bfe_u32 v8, v0, 4, 1
    v_lshl_add_u32 v3, v8, 7, v3
    v_bfe_u32 v9, v0, 3, 1
    v_cmp_eq_u32 vcc, v8, v9
    v_and_b32 v10, 1, v0
    v_lshlrev_b32 v10, 4, v10
    v_mov_b32 v11, 0x3f80
    v_lshlrev_b32 v10, v10, v11
    v_cndmask_b32 v10, 0, v10, vcc
    v_bfe_u32 v9, v0, 1, 2
    v_cmp_eq_u32 vcc, 0, v9
    s_nop 1
    v_cndmask_b32 v4, 0, v10, vcc
    v_cmp_eq_u32 vcc, 1, v9
    s_nop 1
    v_cndmask_b32 v5, 0, v10, vcc
    v_cmp_eq_u32 vcc, 2, v9
    s_nop 1
    v_cndmask_b32 v6, 0, v10, vcc
    v_cmp_eq_u32 vcc, 3, v9
    s_nop 1
    v_cndmask_b32 v7, 0, v10, vcc
    s_mul_i32 s24, s2, 16
    s_mov_b32 s26, 0xffff0000
    s_mov_b32 s25, 100000
    s_waitcnt vmcnt(3)
    v_add_u32 v1, s25, v24
    v_min_u32 v24, v24, v1
    v_lshl_add_u32 v24, v24, 8, v3
    buffer_load_dwordx4 v[40:43], v24, s[16:19], 0 offen
    v_add_u32 v1, s25, v25
    v_min_u32 v25, v25, v1
    v_lshl_add_u32 v25, v25, 8, v3
    buffer_load_dwordx4 v[44:47], v25, s[16:19], 0 offen
    v_add_u32 v1, s25, v26
    v_min_u32 v26, v26, v1
    v_lshl_add_u32 v26, v26, 8, v3
    buffer_load_dwordx4 v[48:51], v26, s[16:19], 0 offen
    v_add_u32 v1, s25, v27
    v_min_u32 v27, v27, v1
    v_lshl_add_u32 v27, v27, 8, v3
    buffer_load_dwordx4 v[52:55], v27, s[16:19], 0 offen
    s_waitcnt vmcnt(6)
    v_add_u32 v1, s25, v28
    v_min_u32 v28, v28, v1
    v_lshl_add_u32 v28, v28, 8, v3
    buffer_load_dwordx4 v[56:59], v28, s[16:19], 0 offen
    v_add_u32 v1, s25, v29
    v_min_u32 v29, v29, v1
    v_lshl_add_u32 v29, v29, 8, v3
    buffer_load_dwordx4 v[60:63], v29, s[16:19], 0 offen
    v_add_u32 v1, s25, v30
    v_min_u32 v30, v30, v1
    v_lshl_add_u32 v30, v30, 8, v3
    buffer_load_dwordx4 v[64:67], v30, s[16:19], 0 offen
    v_add_u32 v1, s25, v31
    v_min_u32 v31, v31, v1
    v_lshl_add_u32 v31, v31, 8, v3
    buffer_load_dwordx4 v[68:71], v31, s[16:19], 0 offen
    s_waitcnt vmcnt(9)
    v_add_u32 v1, s25, v32
    v_min_u32 v32, v32, v1
    v_lshl_add_u32 v32, v32, 8, v3
    buffer_load_dwordx4 v[72:75], v32, s[16:19], 0 offen
    v_add_u32 v1, s25, v33
    v_min_u32 v33, v33, v1
    v_lshl_add_u32 v33, v33, 8, v3
    buffer_load_dwordx4 v[76:79], v33, s[16:19], 0 offen
    v_add_u32 v1, s25, v34
    v_min_u32 v34, v34, v1
    v_lshl_add_u32 v34, v34, 8, v3
    buffer_load_dwordx4 v[80:83], v34, s[16:19], 0 offen
    v_add_u32 v1, s25, v35
    v_min_u32 v35, v35, v1
    v_lshl_add_u32 v35, v35, 8, v3
    buffer_load_dwordx4 v[84:87], v35, s[16:19], 0 offen
    s_waitcnt vmcnt(12)
    v_add_u32 v1, s25, v36
    v_min_u32 v36, v36, v1
    v_lshl_add_u32 v36, v36, 8, v3
    buffer_load_dwordx4 v[88:91], v36, s[16:19], 0 offen
    s_waitcnt vmcnt(12)
    v_mfma_f32_16x16x32_bf16 v[16:19], v[40:43], v[4:7], 0
    v_lshlrev_b32 v8, 16, v40
    v_and_b32 v9, s26, v40
    v_lshlrev_b32 v10, 16, v41
    v_and_b32 v11, s26, v41
    v_lshlrev_b32 v12, 16, v42
    v_and_b32 v13, s26, v42
    v_lshlrev_b32 v14, 16, v43
    v_and_b32 v15, s26, v43
    v_pk_mul_f32 v[8:9], v[8:9], v[8:9]
    v_pk_mul_f32 v[10:11], v[10:11], v[10:11]
    v_pk_mul_f32 v[12:13], v[12:13], v[12:13]
    v_pk_mul_f32 v[14:15], v[14:15], v[14:15]
    v_cvt_pk_bf16_f32 v40, v8, v9
    v_cvt_pk_bf16_f32 v41, v10, v11
    v_cvt_pk_bf16_f32 v42, v12, v13
    v_cvt_pk_bf16_f32 v43, v14, v15
    s_waitcnt vmcnt(11)
    v_mfma_f32_16x16x32_bf16 v[16:19], v[44:47], v[4:7], v[16:19]
    v_lshlrev_b32 v8, 16, v44
    v_and_b32 v9, s26, v44
    v_lshlrev_b32 v10, 16, v45
    v_and_b32 v11, s26, v45
    v_mfma_f32_16x16x32_bf16 v[20:23], v[40:43], v[4:7], 0
    v_lshlrev_b32 v12, 16, v46
    v_and_b32 v13, s26, v46
    v_lshlrev_b32 v14, 16, v47
    v_and_b32 v15, s26, v47
    v_pk_mul_f32 v[8:9], v[8:9], v[8:9]
    v_pk_mul_f32 v[10:11], v[10:11], v[10:11]
    v_pk_mul_f32 v[12:13], v[12:13], v[12:13]
    v_pk_mul_f32 v[14:15], v[14:15], v[14:15]
    v_cvt_pk_bf16_f32 v44, v8, v9
    v_cvt_pk_bf16_f32 v45, v10, v11
    v_cvt_pk_bf16_f32 v46, v12, v13
    v_cvt_pk_bf16_f32 v47, v14, v15
    s_waitcnt vmcnt(10)
    v_mfma_f32_16x16x32_bf16 v[16:19], v[48:51], v[4:7], v[16:19]
    v_lshlrev_b32 v8, 16, v48
    v_and_b32 v9, s26, v48
    v_lshlrev_b32 v10, 16, v49
    v_and_b32 v11, s26, v49
    v_mfma_f32_16x16x32_bf16 v[20:23], v[44:47], v[4:7], v[20:23]
    v_lshlrev_b32 v12, 16, v50
    v_and_b32 v13, s26, v50
    v_lshlrev_b32 v14, 16, v51
    v_and_b32 v15, s26, v51
    v_pk_mul_f32 v[8:9], v[8:9], v[8:9]
    v_pk_mul_f32 v[10:11], v[10:11], v[10:11]
    v_pk_mul_f32 v[12:13], v[12:13], v[12:13]
    v_pk_mul_f32 v[14:15], v[14:15], v[14:15]
    v_cvt_pk_bf16_f32 v48, v8, v9
    v_cvt_pk_bf16_f32 v49, v10, v11
    v_cvt_pk_bf16_f32 v50, v12, v13
    v_cvt_pk_bf16_f32 v51, v14, v15
    s_waitcnt vmcnt(9)
    v_mfma_f32_16x16x32_bf16 v[16:19], v[52:55], v[4:7], v[16:19]
    v_lshlrev_b32 v8, 16, v52
    v_and_b32 v9, s26, v52
    v_lshlrev_b32 v10, 16, v53
    v_and_b32 v11, s26, v53
    v_mfma_f32_16x16x32_bf16 v[20:23], v[48:51], v[4:7], v[20:23]
    v_lshlrev_b32 v12, 16, v54
    v_and_b32 v13, s26, v54
    v_lshlrev_b32 v14, 16, v55
    v_and_b32 v15, s26, v55
    v_pk_mul_f32 v[8:9], v[8:9], v[8:9]
    v_pk_mul_f32 v[10:11], v[10:11], v[10:11]
    v_pk_mul_f32 v[12:13], v[12:13], v[12:13]
    v_pk_mul_f32 v[14:15], v[14:15], v[14:15]
    v_cvt_pk_bf16_f32 v52, v8, v9
    v_cvt_pk_bf16_f32 v53, v10, v11
    v_cvt_pk_bf16_f32 v54, v12, v13
    v_cvt_pk_bf16_f32 v55, v14, v15
    s_waitcnt vmcnt(8)
    v_mfma_f32_16x16x32_bf16 v[16:19], v[56:59], v[4:7], v[16:19]
    v_lshlrev_b32 v8, 16, v56
    v_and_b32 v9, s26, v56
    v_lshlrev_b32 v10, 16, v57
    v_and_b32 v11, s26, v57
    v_mfma_f32_16x16x32_bf16 v[20:23], v[52:55], v[4:7], v[20:23]
    v_lshlrev_b32 v12, 16, v58
    v_and_b32 v13, s26, v58
    v_lshlrev_b32 v14, 16, v59
    v_and_b32 v15, s26, v59
    v_pk_mul_f32 v[8:9], v[8:9], v[8:9]
    v_pk_mul_f32 v[10:11], v[10:11], v[10:11]
    v_pk_mul_f32 v[12:13], v[12:13], v[12:13]
    v_pk_mul_f32 v[14:15], v[14:15], v[14:15]
    v_cvt_pk_bf16_f32 v56, v8, v9
    v_cvt_pk_bf16_f32 v57, v10, v11
    v_cvt_pk_bf16_f32 v58, v12, v13
    v_cvt_pk_bf16_f32 v59, v14, v15
    s_waitcnt vmcnt(7)
    v_mfma_f32_16x16x32_bf16 v[16:19], v[60:63], v[4:7], v[16:19]
    v_lshlrev_b32 v8, 16, v60
    v_and_b32 v9, s26, v60
    v_lshlrev_b32 v10, 16, v61
    v_and_b32 v11, s26, v61
    v_mfma_f32_16x16x32_bf16 v[20:23], v[56:59], v[4:7], v[20:23]
    v_lshlrev_b32 v12, 16, v62
    v_and_b32 v13, s26, v62
    v_lshlrev_b32 v14, 16, v63
    v_and_b32 v15, s26, v63
    v_pk_mul_f32 v[8:9], v[8:9], v[8:9]
    v_pk_mul_f32 v[10:11], v[10:11], v[10:11]
    v_pk_mul_f32 v[12:13], v[12:13], v[12:13]
    v_pk_mul_f32 v[14:15], v[14:15], v[14:15]
    v_cvt_pk_bf16_f32 v60, v8, v9
    v_cvt_pk_bf16_f32 v61, v10, v11
    v_cvt_pk_bf16_f32 v62, v12, v13
    v_cvt_pk_bf16_f32 v63, v14, v15
    s_waitcnt vmcnt(6)
    v_mfma_f32_16x16x32_bf16 v[16:19], v[64:67], v[4:7], v[16:19]
    v_lshlrev_b32 v8, 16, v64
    v_and_b32 v9, s26, v64
    v_lshlrev_b32 v10, 16, v65
    v_and_b32 v11, s26, v65
    v_mfma_f32_16x16x32_bf16 v[20:23], v[60:63], v[4:7], v[20:23]
    v_lshlrev_b32 v12, 16, v66
    v_and_b32 v13, s26, v66
    v_lshlrev_b32 v14, 16, v67
    v_and_b32 v15, s26, v67
    v_pk_mul_f32 v[8:9], v[8:9], v[8:9]
    v_pk_mul_f32 v[10:11], v[10:11], v[10:11]
    v_pk_mul_f32 v[12:13], v[12:13], v[12:13]
    v_pk_mul_f32 v[14:15], v[14:15], v[14:15]
    v_cvt_pk_bf16_f32 v64, v8, v9
    v_cvt_pk_bf16_f32 v65, v10, v11
    v_cvt_pk_bf16_f32 v66, v12, v13
    v_cvt_pk_bf16_f32 v67, v14, v15
    s_waitcnt vmcnt(5)
    v_mfma_f32_16x16x32_bf16 v[16:19], v[68:71], v[4:7], v[16:19]
    v_lshlrev_b32 v8, 16, v68
    v_and_b32 v9, s26, v68
    v_lshlrev_b32 v10, 16, v69
    v_and_b32 v11, s26, v69
    v_mfma_f32_16x16x32_bf16 v[20:23], v[64:67], v[4:7], v[20:23]
    v_lshlrev_b32 v12, 16, v70
    v_and_b32 v13, s26, v70
    v_lshlrev_b32 v14, 16, v71
    v_and_b32 v15, s26, v71
    v_pk_mul_f32 v[8:9], v[8:9], v[8:9]
    v_pk_mul_f32 v[10:11], v[10:11], v[10:11]
    v_pk_mul_f32 v[12:13], v[12:13], v[12:13]
    v_pk_mul_f32 v[14:15], v[14:15], v[14:15]
    v_cvt_pk_bf16_f32 v68, v8, v9
    v_cvt_pk_bf16_f32 v69, v10, v11
    v_cvt_pk_bf16_f32 v70, v12, v13
    v_cvt_pk_bf16_f32 v71, v14, v15
    s_waitcnt vmcnt(4)
    v_mfma_f32_16x16x32_bf16 v[16:19], v[72:75], v[4:7], v[16:19]
    v_lshlrev_b32 v8, 16, v72
    v_and_b32 v9, s26, v72
    v_lshlrev_b32 v10, 16, v73
    v_and_b32 v11, s26, v73
    v_mfma_f32_16x16x32_bf16 v[20:23], v[68:71], v[4:7], v[20:23]
    v_lshlrev_b32 v12, 16, v74
    v_and_b32 v13, s26, v74
    v_lshlrev_b32 v14, 16, v75
    v_and_b32 v15, s26, v75
    v_pk_mul_f32 v[8:9], v[8:9], v[8:9]
    v_pk_mul_f32 v[10:11], v[10:11], v[10:11]
    v_pk_mul_f32 v[12:13], v[12:13], v[12:13]
    v_pk_mul_f32 v[14:15], v[14:15], v[14:15]
    v_cvt_pk_bf16_f32 v72, v8, v9
    v_cvt_pk_bf16_f32 v73, v10, v11
    v_cvt_pk_bf16_f32 v74, v12, v13
    v_cvt_pk_bf16_f32 v75, v14, v15
    s_waitcnt vmcnt(3)
    v_mfma_f32_16x16x32_bf16 v[16:19], v[76:79], v[4:7], v[16:19]
    v_lshlrev_b32 v8, 16, v76
    v_and_b32 v9, s26, v76
    v_lshlrev_b32 v10, 16, v77
    v_and_b32 v11, s26, v77
    v_mfma_f32_16x16x32_bf16 v[20:23], v[72:75], v[4:7], v[20:23]
    v_lshlrev_b32 v12, 16, v78
    v_and_b32 v13, s26, v78
    v_lshlrev_b32 v14, 16, v79
    v_and_b32 v15, s26, v79
    v_pk_mul_f32 v[8:9], v[8:9], v[8:9]
    v_pk_mul_f32 v[10:11], v[10:11], v[10:11]
    v_pk_mul_f32 v[12:13], v[12:13], v[12:13]
    v_pk_mul_f32 v[14:15], v[14:15], v[14:15]
    v_cvt_pk_bf16_f32 v76, v8, v9
    v_cvt_pk_bf16_f32 v77, v10, v11
    v_cvt_pk_bf16_f32 v78, v12, v13
    v_cvt_pk_bf16_f32 v79, v14, v15
    s_waitcnt vmcnt(2)
    v_mfma_f32_16x16x32_bf16 v[16:19], v[80:83], v[4:7], v[16:19]
    v_lshlrev_b32 v8, 16, v80
    v_and_b32 v9, s26, v80
    v_lshlrev_b32 v10, 16, v81
    v_and_b32 v11, s26, v81
    v_mfma_f32_16x16x32_bf16 v[20:23], v[76:79], v[4:7], v[20:23]
    v_lshlrev_b32 v12, 16, v82
    v_and_b32 v13, s26, v82
    v_lshlrev_b32 v14, 16, v83
    v_and_b32 v15, s26, v83
    v_pk_mul_f32 v[8:9], v[8:9], v[8:9]
    v_pk_mul_f32 v[10:11], v[10:11], v[10:11]
    v_pk_mul_f32 v[12:13], v[12:13], v[12:13]
    v_pk_mul_f32 v[14:15], v[14:15], v[14:15]
    v_cvt_pk_bf16_f32 v80, v8, v9
    v_cvt_pk_bf16_f32 v81, v10, v11
    v_cvt_pk_bf16_f32 v82, v12, v13
    v_cvt_pk_bf16_f32 v83, v14, v15
    s_waitcnt vmcnt(1)
    v_mfma_f32_16x16x32_bf16 v[16:19], v[84:87], v[4:7], v[16:19]
    v_lshlrev_b32 v8, 16, v84
    v_and_b32 v9, s26, v84
    v_lshlrev_b32 v10, 16, v85
    v_and_b32 v11, s26, v85
    v_mfma_f32_16x16x32_bf16 v[20:23], v[80:83], v[4:7], v[20:23]
    v_lshlrev_b32 v12, 16, v86
    v_and_b32 v13, s26, v86
    v_lshlrev_b32 v14, 16, v87
    v_and_b32 v15, s26, v87
    v_pk_mul_f32 v[8:9], v[8:9], v[8:9]
    v_pk_mul_f32 v[10:11], v[10:11], v[10:11]
    v_pk_mul_f32 v[12:13], v[12:13], v[12:13]
    v_pk_mul_f32 v[14:15], v[14:15], v[14:15]
    v_cvt_pk_bf16_f32 v84, v8, v9
    v_cvt_pk_bf16_f32 v85, v10, v11
    v_cvt_pk_bf16_f32 v86, v12, v13
    v_cvt_pk_bf16_f32 v87, v14, v15
    s_nop 1
    v_mfma_f32_16x16x32_bf16 v[20:23], v[84:87], v[4:7], v[20:23]
    s_waitcnt vmcnt(0)
    v_mfma_f32_16x16x32_bf16 v[16:19], v[88:91], v[4:7], v[16:19]
    v_lshlrev_b32 v8, 16, v88
    v_and_b32 v9, s26, v88
    v_lshlrev_b32 v10, 16, v89
    v_and_b32 v11, s26, v89
    v_lshlrev_b32 v12, 16, v90
    v_and_b32 v13, s26, v90
    v_lshlrev_b32 v14, 16, v91
    v_and_b32 v15, s26, v91
    v_pk_mul_f32 v[8:9], v[8:9], v[8:9]
    v_pk_mul_f32 v[10:11], v[10:11], v[10:11]
    v_pk_mul_f32 v[12:13], v[12:13], v[12:13]
    v_pk_mul_f32 v[14:15], v[14:15], v[14:15]
    v_cvt_pk_bf16_f32 v88, v8, v9
    v_cvt_pk_bf16_f32 v89, v10, v11
    v_cvt_pk_bf16_f32 v90, v12, v13
    v_cvt_pk_bf16_f32 v91, v14, v15
    v_cvt_pk_bf16_f32 v24, v16, v17
    v_cvt_pk_bf16_f32 v25, v18, v19
    v_mfma_f32_16x16x32_bf16 v[20:23], v[88:91], v[4:7], v[20:23]
    v_lshlrev_b32 v8, 16, v24
    v_and_b32 v9, s26, v24
    v_lshlrev_b32 v10, 16, v25
    v_and_b32 v11, s26, v25
    v_pk_mul_f32 v[8:9], v[8:9], v[8:9]
    v_pk_mul_f32 v[10:11], v[10:11], v[10:11]
    v_cvt_pk_bf16_f32 v24, v8, v9
    v_cvt_pk_bf16_f32 v25, v10, v11
    v_cvt_pk_bf16_f32 v26, v20, v21
    v_cvt_pk_bf16_f32 v27, v22, v23
    v_lshlrev_b32 v8, 16, v24
    v_and_b32 v9, s26, v24
    v_lshlrev_b32 v10, 16, v25
    v_and_b32 v11, s26, v25
    v_lshlrev_b32 v12, 16, v26
    v_and_b32 v13, s26, v26
    v_lshlrev_b32 v14, 16, v27
    v_and_b32 v15, s26, v27
    v_pk_add_f32 v[8:9], v[8:9], v[12:13] neg_lo:[0,1] neg_hi:[0,1]
    v_pk_add_f32 v[10:11], v[10:11], v[14:15] neg_lo:[0,1] neg_hi:[0,1]
    v_cvt_pk_bf16_f32 v24, v8, v9
    v_cvt_pk_bf16_f32 v25, v10, v11
    v_lshlrev_b32 v8, 16, v24
    v_and_b32 v9, s26, v24
    v_lshlrev_b32 v10, 16, v25
    v_and_b32 v11, s26, v25
    v_pk_add_f32 v[8:9], v[8:9], v[10:11]
    v_add_f32 v28, v8, v9
    s_nop 1
    v_add_f32_dpp v28, v28, v28 row_shr:1 row_mask:0xf bank_mask:0xf bound_ctrl:0
    s_nop 1
    v_add_f32_dpp v28, v28, v28 row_shr:2 row_mask:0xf bank_mask:0xf bound_ctrl:0
    s_nop 1
    v_add_f32_dpp v28, v28, v28 row_shr:4 row_mask:0xf bank_mask:0xf bound_ctrl:0
    s_nop 1
    v_add_f32_dpp v28, v28, v28 row_shr:8 row_mask:0xf bank_mask:0xf bound_ctrl:0
    s_nop 1
    v_add_f32_dpp v28, v28, v28 row_bcast:15 row_mask:0xa bank_mask:0xf
    s_mov_b32 exec_lo, 0x80000000
    s_mov_b32 exec_hi, 0x80000000
    v_mul_f32 v28, 0.5, v28
    v_cvt_pk_bf16_f32 v28, v28, v28
    buffer_store_short v28, v2, s[20:23], s24 offen offset:0
L_end:
    s_endpgm
.section .rodata,"a"
.p2align 6
.amdhsa_kernel standalone__fm_second_order__recsys_kernel
  .amdhsa_next_free_vgpr 92
  .amdhsa_next_free_sgpr 32
  .amdhsa_accum_offset 92
  .amdhsa_group_segment_fixed_size 0
  .amdhsa_kernarg_size 40
  .amdhsa_user_sgpr_count 2
  .amdhsa_user_sgpr_kernarg_segment_ptr 1
  .amdhsa_system_sgpr_workgroup_id_x 1
.end_amdhsa_kernel
```
